```python
import torch

def _softmax(x, axis=-1):
    return torch.softmax(x, dim=axis)
def _gelu(x):
    return torch.nn.functional.gelu(x, approximate="tanh")
def _silu(x):
    return torch.nn.functional.silu(x)
def _sigmoid(x):
    return torch.sigmoid(x)
def _layernorm(x, axis=-1, eps=1e-5):
    m = x.mean(dim=axis, keepdim=True)
    v = x.var(dim=axis, keepdim=True, unbiased=False)
    return (x - m) / torch.sqrt(v + eps)
def _scatter_add(tgt, idx, src, axis=0):
    return tgt.clone().index_add_(axis, idx, src)
def _segment_sum(src, seg, n):
    out = torch.zeros((n,) + src.shape[1:], dtype=src.dtype)
    return out.index_add_(0, seg, src)
def _pad(x, pw):
    flat = tuple(v for pair in reversed(pw) for v in pair)
    return torch.nn.functional.pad(x, flat)

kernel_name = 'standalone__softmax_full_bidir__sampling'

def setup_inputs():

    _w = (lambda a: (lambda t: t.to(torch.bfloat16) if t.is_floating_point() else t)(torch.as_tensor(a)))
    B, H, Sq, Skv, Dh = 16, 32, 4, 4096, 128
    return {
        "q": _w((lambda *s: torch.randn(*s, dtype=torch.bfloat16) * 0.8)(B, H, Sq, Dh)),
        "k": _w((lambda *s: torch.randn(*s, dtype=torch.bfloat16) * 0.8)(B, H, Skv, Dh)),
        "v": _w((lambda *s: torch.randn(*s, dtype=torch.bfloat16) * 0.05)(B, H, Skv, Dh)),
    }

def reference(q, k, v):
    scale = q.shape[-1] ** -0.5
    scores = torch.einsum('bhqd,bhkd->bhqk', q, k) * scale
    attn = _softmax(scores, axis=-1)
    return torch.einsum('bhqk,bhkd->bhqd', attn, v)
```

```asm
; @launch grid=(256,1,1) block=(256,1,1) lds=147728
.amdgcn_target "amdgcn-amd-amdhsa--gfx950"
.text
.globl standalone__softmax_full_bidir__sampling_kernel
.p2align 8
.type standalone__softmax_full_bidir__sampling_kernel,@function
standalone__softmax_full_bidir__sampling_kernel:
    s_load_dwordx2 s[16:17], s[0:1], 8
    v_readfirstlane_b32 s32, v0
    s_cmp_ge_u32 s2, 256
    s_cbranch_scc1 L_end
    s_bitcmp1_b32 s2, 0
    s_cselect_b32 s72, 0x10000000, 0
    s_bitcmp1_b32 s2, 1
    s_cselect_b32 s37, 0x1000000, 0
    s_xor_b32 s72, s72, s37
    s_bitcmp1_b32 s2, 2
    s_cselect_b32 s37, 0x8000000, 0
    s_xor_b32 s72, s72, s37
    s_bitcmp1_b32 s2, 3
    s_cselect_b32 s37, 0x200000, 0
    s_xor_b32 s72, s72, s37
    s_bitcmp1_b32 s2, 4
    s_cselect_b32 s37, 0x8880000, 0
    s_xor_b32 s72, s72, s37
    s_bitcmp1_b32 s2, 5
    s_cselect_b32 s37, 0x4400000, 0
    s_xor_b32 s72, s72, s37
    s_bitcmp1_b32 s2, 6
    s_cselect_b32 s37, 0x400000, 0
    s_xor_b32 s72, s72, s37
    s_bitcmp1_b32 s2, 7
    s_cselect_b32 s37, 0x2001000, 0
    s_xor_b32 s72, s72, s37
    s_bitcmp1_b32 s32, 6
    s_cselect_b32 s37, 0x2000, 0
    s_xor_b32 s72, s72, s37
    s_bitcmp1_b32 s32, 7
    s_cselect_b32 s37, 0x800, 0
    s_xor_b32 s72, s72, s37
    v_and_b32 v11, 3, v0
    v_and_b32 v8, 48, v0
    v_bfe_u32 v10, v0, 2, 2
    v_lshlrev_b32 v8, 2, v8
    v_lshl_add_u32 v1, v11, 4, v8
    v_lshl_add_u32 v1, v10, 9, v1
    s_brev_b32 s18, 4
    s_mov_b32 s19, 0x20000
    s_waitcnt lgkmcnt(0)
    buffer_load_dwordx4 v[104:107], v1, s[16:19], s72 offen nt
    s_load_dwordx2 s[24:25], s[0:1], 0
    s_load_dwordx2 s[20:21], s[0:1], 16
    s_load_dwordx2 s[28:29], s[0:1], 24
    s_load_dwordx2 s[12:13], s[0:1], 32
    s_xor_b32 s73, s72, 0x10000
    buffer_load_dwordx4 v[108:111], v1, s[16:19], s73 offen nt
    s_xor_b32 s74, s72, 0x1000
    buffer_load_dwordx4 v[112:115], v1, s[16:19], s74 offen nt
    s_xor_b32 s75, s72, 0x11000
    buffer_load_dwordx4 v[116:119], v1, s[16:19], s75 offen nt
    s_xor_b32 s76, s72, 0x4000
    buffer_load_dwordx4 v[120:123], v1, s[16:19], s76 offen nt
    s_xor_b32 s77, s72, 0x14000
    buffer_load_dwordx4 v[124:127], v1, s[16:19], s77 offen nt
    s_xor_b32 s78, s72, 0x5000
    buffer_load_dwordx4 v[128:131], v1, s[16:19], s78 offen nt
    s_xor_b32 s79, s72, 0x15000
    buffer_load_dwordx4 v[132:135], v1, s[16:19], s79 offen nt
    v_and_b32 v0, 63, v0
    s_lshr_b32 s32, s32, 6
    v_lshl_add_u32 v3, v11, 8, v8
    v_lshl_add_u32 v3, v10, 4, v3
    s_lshr_b32 s40, s72, 20
    s_lshl_b32 s40, s40, 10
    s_xor_b32 s41, s40, 0x400
    s_mov_b32 s26, 0x80000
    s_mov_b32 s27, 0x20000
    v_mov_b32 v232, 0
    s_waitcnt lgkmcnt(0)
    buffer_load_dwordx4 v[80:83], v3, s[24:27], s40 offen
    buffer_load_dwordx4 v[84:87], v3, s[24:27], s41 offen
    s_mov_b32 s39, 0x8100
    s_xor_b32 s44, s39, s72
    s_xor_b32 s45, s39, s73
    s_xor_b32 s46, s39, s74
    s_xor_b32 s47, s39, s75
    s_xor_b32 s48, s39, s76
    s_xor_b32 s49, s39, s77
    s_xor_b32 s50, s39, s78
    s_xor_b32 s51, s39, s79
    buffer_load_dwordx4 v[136:139], v1, s[16:19], s44 offen nt
    buffer_load_dwordx4 v[140:143], v1, s[16:19], s45 offen nt
    buffer_load_dwordx4 v[144:147], v1, s[16:19], s46 offen nt
    buffer_load_dwordx4 v[148:151], v1, s[16:19], s47 offen nt
    buffer_load_dwordx4 v[152:155], v1, s[16:19], s48 offen nt
    buffer_load_dwordx4 v[156:159], v1, s[16:19], s49 offen nt
    buffer_load_dwordx4 v[160:163], v1, s[16:19], s50 offen nt
    buffer_load_dwordx4 v[164:167], v1, s[16:19], s51 offen nt
    s_mov_b32 s39, 0x40800
    s_xor_b32 s44, s39, s72
    s_xor_b32 s45, s39, s73
    s_xor_b32 s46, s39, s74
    s_xor_b32 s47, s39, s75
    s_xor_b32 s48, s39, s76
    s_xor_b32 s49, s39, s77
    s_xor_b32 s50, s39, s78
    s_xor_b32 s51, s39, s79
    v_and_b32 v7, 15, v0
    v_bfe_u32 v2, v0, 4, 1
    v_lshlrev_b32 v2, 9, v2
    v_lshl_add_u32 v2, v7, 4, v2
    v_lshrrev_b32 v9, 5, v0
    v_lshl_add_u32 v2, v9, 10, v2
    s_mov_b32 s33, 0x3e0293ee
    s_mov_b32 s34, 0x05040100
    s_mov_b32 s35, 0x07060302
    s_mov_b32 s30, 0x80000
    s_mov_b32 s31, 0x20000
    v_lshlrev_b32 v88, 1, v8
    v_lshl_add_u32 v91, v11, 5, v88
    v_lshl_add_u32 v234, v10, 2, v91
    v_lshl_add_u32 v88, v11, 9, v88
    s_lshl_b32 s38, s32, 11
    s_add_u32 s38, s38, 131072
    v_add_u32 v88, s38, v88
    v_lshlrev_b32 v237, 4, v11
    v_add_u32 v237, 147456, v237
    s_lshl_b32 s37, s32, 2
    v_add_u32 v89, s37, v237
    v_mov_b32 v238, 147712
    v_add_u32 v239, s37, v238
    s_lshl_b32 s37, s32, 15
    v_add_u32 v90, s37, v234
    v_add_u32 v91, s37, v91
    s_lshl_b32 s37, s32, 9
    s_add_u32 s37, s37, 131072
    v_add_u32 v234, s37, v234
    s_lshl_b32 s37, s32, 4
    s_add_u32 s37, s37, 147456
    v_mov_b32 v235, s37
    s_lshl_b32 s37, s32, 8
    v_lshl_add_u32 v236, v0, 2, s37
    ds_write_b32 v239, v232
    v_mov_b32 v9, 0xff800000
    s_mov_b32 s36, 0
    v_mov_b32 v93, 0
    v_mov_b32 v233, 1
    s_mov_b64 vcc, 0
    s_mov_b64 s[52:53], 0
    s_getreg_b32 s37, hwreg(HW_REG_XCC_ID)
    s_bitcmp1_b32 s37, 0
    s_mov_b32 s43, 0x80402
    s_cselect_b32 s43, 0x0, s43
    s_lshl_b32 s43, s43, s32
    v_mov_b32 v16, 0
    v_mov_b32 v17, 0
    v_mov_b32 v18, 0
    v_mov_b32 v19, 0
    v_mov_b32 v20, 0
    v_mov_b32 v21, 0
    v_mov_b32 v22, 0
    v_mov_b32 v23, 0
    v_mov_b32 v24, 0
    v_mov_b32 v25, 0
    v_mov_b32 v26, 0
    v_mov_b32 v27, 0
    v_mov_b32 v28, 0
    v_mov_b32 v29, 0
    v_mov_b32 v30, 0
    v_mov_b32 v31, 0
    v_mov_b32 v32, 0
    v_mov_b32 v33, 0
    v_mov_b32 v34, 0
    v_mov_b32 v35, 0
    v_mov_b32 v36, 0
    v_mov_b32 v37, 0
    v_mov_b32 v38, 0
    v_mov_b32 v39, 0
    v_mov_b32 v40, 0
    v_mov_b32 v41, 0
    v_mov_b32 v42, 0
    v_mov_b32 v43, 0
    v_mov_b32 v44, 0
    v_mov_b32 v45, 0
    v_mov_b32 v46, 0
    v_mov_b32 v47, 0
    v_mov_b32 v5, 0
    s_waitcnt lgkmcnt(0)
    s_barrier
.p2align 6
L_kloop:
    s_waitcnt vmcnt(8)
    s_mov_b64 exec, 1
    global_store_dword v232, v233, s[12:13]
    s_mov_b64 exec, -1
    v_mfma_f32_16x16x32_bf16 v[48:51], v[104:107], v[80:83], 0
    v_mfma_f32_16x16x32_bf16 v[52:55], v[108:111], v[80:83], 0
    s_cbranch_vccnz L_w1
    s_waitcnt vmcnt(5)
L_w1:
    s_waitcnt vmcnt(6)
    buffer_load_dwordx4 v[168:171], v1, s[16:19], s44 offen nt
    v_mfma_f32_16x16x32_bf16 v[56:59], v[112:115], v[80:83], 0
    v_mfma_f32_16x16x32_bf16 v[60:63], v[116:119], v[80:83], 0
    v_mfma_f32_16x16x32_bf16 v[64:67], v[120:123], v[80:83], 0
    v_mfma_f32_16x16x32_bf16 v[68:71], v[124:127], v[80:83], 0
    v_mfma_f32_16x16x32_bf16 v[72:75], v[128:131], v[80:83], 0
    s_cbranch_vccnz L_w2
    s_waitcnt vmcnt(5)
L_w2:
    s_waitcnt vmcnt(6)
    buffer_load_dwordx4 v[172:175], v1, s[16:19], s45 offen nt
    v_mfma_f32_16x16x32_bf16 v[76:79], v[132:135], v[80:83], 0
    s_nop 0
    v_add_f32_dpp v48, v49, v48 row_ror:12 row_mask:0xf bank_mask:0xf
    v_add_f32_dpp v53, v54, v53 row_ror:12 row_mask:0xf bank_mask:0xf
    v_add_f32_dpp v58, v59, v58 row_ror:12 row_mask:0xf bank_mask:0xf
    s_cbranch_vccnz L_w3
    s_waitcnt vmcnt(5)
L_w3:
    s_waitcnt vmcnt(6)
    buffer_load_dwordx4 v[176:179], v1, s[16:19], s46 offen nt
    v_add_f32_dpp v63, v60, v63 row_ror:12 row_mask:0xf bank_mask:0xf
    v_add_f32_dpp v64, v65, v64 row_ror:12 row_mask:0xf bank_mask:0xf
    v_add_f32_dpp v69, v70, v69 row_ror:12 row_mask:0xf bank_mask:0xf
    v_add_f32_dpp v74, v75, v74 row_ror:12 row_mask:0xf bank_mask:0xf
    v_add_f32_dpp v79, v76, v79 row_ror:12 row_mask:0xf bank_mask:0xf
    s_cbranch_vccnz L_w4
    s_waitcnt vmcnt(5)
L_w4:
    s_waitcnt vmcnt(6)
    buffer_load_dwordx4 v[180:183], v1, s[16:19], s47 offen nt
    v_add_f32_dpp v48, v50, v48 row_ror:8 row_mask:0xf bank_mask:0xf
    v_add_f32_dpp v64, v66, v64 row_ror:8 row_mask:0xf bank_mask:0xf
    v_add_f32_dpp v53, v55, v53 row_ror:8 row_mask:0xf bank_mask:0xf
    v_add_f32_dpp v69, v71, v69 row_ror:8 row_mask:0xf bank_mask:0xf
    v_add_f32_dpp v94, v51, v48 row_ror:4 row_mask:0xf bank_mask:0x1
    s_cbranch_vccnz L_w5
    s_waitcnt vmcnt(4)
L_w5:
    s_waitcnt vmcnt(6)
    buffer_load_dwordx4 v[184:187], v1, s[16:19], s48 offen nt
    v_add_f32_dpp v58, v56, v58 row_ror:8 row_mask:0xf bank_mask:0xf
    v_add_f32_dpp v95, v67, v64 row_ror:4 row_mask:0xf bank_mask:0x1
    v_add_f32_dpp v74, v72, v74 row_ror:8 row_mask:0xf bank_mask:0xf
    v_add_f32_dpp v94, v52, v53 row_ror:4 row_mask:0xf bank_mask:0x2
    v_add_f32_dpp v63, v61, v63 row_ror:8 row_mask:0xf bank_mask:0xf
    s_cbranch_vccnz L_w6
    s_waitcnt vmcnt(4)
L_w6:
    s_waitcnt vmcnt(5)
    buffer_load_dwordx4 v[188:191], v1, s[16:19], s49 offen nt
    v_add_f32_dpp v95, v68, v69 row_ror:4 row_mask:0xf bank_mask:0x2
    v_add_f32_dpp v79, v77, v79 row_ror:8 row_mask:0xf bank_mask:0xf
    s_nop 0
    v_add_f32_dpp v94, v57, v58 row_ror:4 row_mask:0xf bank_mask:0x4
    s_nop 0
    s_cbranch_vccnz L_w7
    s_waitcnt vmcnt(4)
L_w7:
    s_waitcnt vmcnt(5)
    buffer_load_dwordx4 v[192:195], v1, s[16:19], s50 offen nt
    v_add_f32_dpp v95, v73, v74 row_ror:4 row_mask:0xf bank_mask:0x4
    s_nop 0
    v_add_f32_dpp v94, v62, v63 row_ror:4 row_mask:0xf bank_mask:0x8
    s_nop 0
    v_add_f32_dpp v95, v78, v79 row_ror:4 row_mask:0xf bank_mask:0x8
    s_cbranch_vccnz L_w8
    s_waitcnt vmcnt(4)
L_w8:
    s_waitcnt vmcnt(5)
    buffer_load_dwordx4 v[196:199], v1, s[16:19], s51 offen nt
    ds_write_b32 v90, v94 offset:0
    ds_write_b32 v90, v95 offset:16
    v_max3_f32 v9, v94, v95, v9
    s_xor_b32 s39, s39, 0x8100
    s_xor_b32 s44, s39, s72
    s_xor_b32 s45, s39, s73
    s_xor_b32 s46, s39, s74
    s_xor_b32 s47, s39, s75
    s_xor_b32 s48, s39, s76
    s_xor_b32 s49, s39, s77
    s_xor_b32 s50, s39, s78
    s_xor_b32 s51, s39, s79
    s_waitcnt vmcnt(8)
    v_mfma_f32_16x16x32_bf16 v[48:51], v[136:139], v[80:83], 0
    v_mfma_f32_16x16x32_bf16 v[52:55], v[140:143], v[80:83], 0
    s_cbranch_vccnz L_w9
    s_waitcnt vmcnt(4)
L_w9:
    s_waitcnt vmcnt(5)
    buffer_load_dwordx4 v[200:203], v1, s[16:19], s44 offen nt
    v_mfma_f32_16x16x32_bf16 v[56:59], v[144:147], v[80:83], 0
    v_mfma_f32_16x16x32_bf16 v[60:63], v[148:151], v[80:83], 0
    v_mfma_f32_16x16x32_bf16 v[64:67], v[152:155], v[80:83], 0
    v_mfma_f32_16x16x32_bf16 v[68:71], v[156:159], v[80:83], 0
    v_mfma_f32_16x16x32_bf16 v[72:75], v[160:163], v[80:83], 0
    s_cbranch_vccnz L_w10
    s_waitcnt vmcnt(4)
L_w10:
    s_waitcnt vmcnt(5)
    buffer_load_dwordx4 v[204:207], v1, s[16:19], s45 offen nt
    v_mfma_f32_16x16x32_bf16 v[76:79], v[164:167], v[80:83], 0
    s_nop 0
    v_add_f32_dpp v48, v49, v48 row_ror:12 row_mask:0xf bank_mask:0xf
    v_add_f32_dpp v53, v54, v53 row_ror:12 row_mask:0xf bank_mask:0xf
    v_add_f32_dpp v58, v59, v58 row_ror:12 row_mask:0xf bank_mask:0xf
    s_cbranch_vccnz L_w11
    s_waitcnt vmcnt(4)
L_w11:
    s_waitcnt vmcnt(5)
    buffer_load_dwordx4 v[208:211], v1, s[16:19], s46 offen nt
    v_add_f32_dpp v63, v60, v63 row_ror:12 row_mask:0xf bank_mask:0xf
    v_add_f32_dpp v64, v65, v64 row_ror:12 row_mask:0xf bank_mask:0xf
    v_add_f32_dpp v69, v70, v69 row_ror:12 row_mask:0xf bank_mask:0xf
    v_add_f32_dpp v74, v75, v74 row_ror:12 row_mask:0xf bank_mask:0xf
    v_add_f32_dpp v79, v76, v79 row_ror:12 row_mask:0xf bank_mask:0xf
    s_cbranch_vccnz L_w12
    s_waitcnt vmcnt(4)
L_w12:
    s_waitcnt vmcnt(5)
    buffer_load_dwordx4 v[212:215], v1, s[16:19], s47 offen nt
    v_add_f32_dpp v48, v50, v48 row_ror:8 row_mask:0xf bank_mask:0xf
    v_add_f32_dpp v64, v66, v64 row_ror:8 row_mask:0xf bank_mask:0xf
    v_add_f32_dpp v53, v55, v53 row_ror:8 row_mask:0xf bank_mask:0xf
    v_add_f32_dpp v69, v71, v69 row_ror:8 row_mask:0xf bank_mask:0xf
    v_add_f32_dpp v94, v51, v48 row_ror:4 row_mask:0xf bank_mask:0x1
    s_cbranch_vccnz L_w13
    s_waitcnt vmcnt(4)
L_w13:
    s_waitcnt vmcnt(5)
    buffer_load_dwordx4 v[216:219], v1, s[16:19], s48 offen nt
    v_add_f32_dpp v58, v56, v58 row_ror:8 row_mask:0xf bank_mask:0xf
    v_add_f32_dpp v95, v67, v64 row_ror:4 row_mask:0xf bank_mask:0x1
    v_add_f32_dpp v74, v72, v74 row_ror:8 row_mask:0xf bank_mask:0xf
    v_add_f32_dpp v94, v52, v53 row_ror:4 row_mask:0xf bank_mask:0x2
    v_add_f32_dpp v63, v61, v63 row_ror:8 row_mask:0xf bank_mask:0xf
    s_cbranch_vccnz L_w14
    s_waitcnt vmcnt(4)
L_w14:
    s_waitcnt vmcnt(5)
    buffer_load_dwordx4 v[220:223], v1, s[16:19], s49 offen nt
    v_add_f32_dpp v95, v68, v69 row_ror:4 row_mask:0xf bank_mask:0x2
    v_add_f32_dpp v79, v77, v79 row_ror:8 row_mask:0xf bank_mask:0xf
    s_nop 0
    v_add_f32_dpp v94, v57, v58 row_ror:4 row_mask:0xf bank_mask:0x4
    s_nop 0
    s_cbranch_vccnz L_w15
    s_waitcnt vmcnt(4)
L_w15:
    s_waitcnt vmcnt(5)
    buffer_load_dwordx4 v[224:227], v1, s[16:19], s50 offen nt
    v_add_f32_dpp v95, v73, v74 row_ror:4 row_mask:0xf bank_mask:0x4
    s_nop 0
    v_add_f32_dpp v94, v62, v63 row_ror:4 row_mask:0xf bank_mask:0x8
    s_nop 0
    v_add_f32_dpp v95, v78, v79 row_ror:4 row_mask:0xf bank_mask:0x8
    s_cbranch_vccnz L_w16
    s_waitcnt vmcnt(4)
L_w16:
    s_waitcnt vmcnt(5)
    buffer_load_dwordx4 v[228:231], v1, s[16:19], s51 offen nt
    ds_write_b32 v90, v94 offset:512
    ds_write_b32 v90, v95 offset:528
    v_max3_f32 v9, v94, v95, v9
    s_add_u32 s38, s36, 1
    s_bitcmp1_b32 s38, 0
    s_cselect_b32 s39, 0x20000, 0
    s_bitcmp1_b32 s38, 1
    s_cselect_b32 s37, 0x84000, 0
    s_xor_b32 s39, s39, s37
    s_bitcmp1_b32 s38, 2
    s_cselect_b32 s37, 0x100, 0
    s_xor_b32 s39, s39, s37
    s_bitcmp1_b32 s38, 3
    s_cselect_b32 s37, 0x100000, 0
    s_xor_b32 s39, s39, s37
    s_xor_b32 s44, s39, s72
    s_xor_b32 s45, s39, s73
    s_xor_b32 s46, s39, s74
    s_xor_b32 s47, s39, s75
    s_xor_b32 s48, s39, s76
    s_xor_b32 s49, s39, s77
    s_xor_b32 s50, s39, s78
    s_xor_b32 s51, s39, s79
    s_cmp_lg_u32 s36, 15
    s_cbranch_scc1 L_nosw
    s_mov_b64 s[16:17], s[20:21]
    v_mov_b32 v1, v2
L_nosw:
    s_waitcnt vmcnt(8)
    s_mov_b64 exec, 1
    global_load_dword v93, v232, s[12:13] offset:4 sc1
    s_mov_b64 exec, -1
    v_mfma_f32_16x16x32_bf16 v[48:51], v[168:171], v[80:83], 0
    v_mfma_f32_16x16x32_bf16 v[52:55], v[172:175], v[80:83], 0
    s_cbranch_vccnz L_w17
    s_waitcnt vmcnt(5)
L_w17:
    s_waitcnt vmcnt(6)
    buffer_load_dwordx4 v[104:107], v1, s[16:19], s44 offen nt
    v_mfma_f32_16x16x32_bf16 v[56:59], v[176:179], v[80:83], 0
    v_mfma_f32_16x16x32_bf16 v[60:63], v[180:183], v[80:83], 0
    v_mfma_f32_16x16x32_bf16 v[64:67], v[184:187], v[80:83], 0
    v_mfma_f32_16x16x32_bf16 v[68:71], v[188:191], v[80:83], 0
    v_mfma_f32_16x16x32_bf16 v[72:75], v[192:195], v[80:83], 0
    s_cbranch_vccnz L_w18
    s_waitcnt vmcnt(5)
L_w18:
    s_waitcnt vmcnt(6)
    buffer_load_dwordx4 v[108:111], v1, s[16:19], s45 offen nt
    v_mfma_f32_16x16x32_bf16 v[76:79], v[196:199], v[80:83], 0
    s_nop 0
    v_add_f32_dpp v48, v49, v48 row_ror:12 row_mask:0xf bank_mask:0xf
    v_add_f32_dpp v53, v54, v53 row_ror:12 row_mask:0xf bank_mask:0xf
    v_add_f32_dpp v58, v59, v58 row_ror:12 row_mask:0xf bank_mask:0xf
    s_cbranch_vccnz L_w19
    s_waitcnt vmcnt(5)
L_w19:
    s_waitcnt vmcnt(6)
    buffer_load_dwordx4 v[112:115], v1, s[16:19], s46 offen nt
    v_add_f32_dpp v63, v60, v63 row_ror:12 row_mask:0xf bank_mask:0xf
    v_add_f32_dpp v64, v65, v64 row_ror:12 row_mask:0xf bank_mask:0xf
    v_add_f32_dpp v69, v70, v69 row_ror:12 row_mask:0xf bank_mask:0xf
    v_add_f32_dpp v74, v75, v74 row_ror:12 row_mask:0xf bank_mask:0xf
    v_add_f32_dpp v79, v76, v79 row_ror:12 row_mask:0xf bank_mask:0xf
    s_cbranch_vccnz L_w20
    s_waitcnt vmcnt(5)
L_w20:
    s_waitcnt vmcnt(6)
    buffer_load_dwordx4 v[116:119], v1, s[16:19], s47 offen nt
    v_add_f32_dpp v48, v50, v48 row_ror:8 row_mask:0xf bank_mask:0xf
    v_add_f32_dpp v64, v66, v64 row_ror:8 row_mask:0xf bank_mask:0xf
    v_add_f32_dpp v53, v55, v53 row_ror:8 row_mask:0xf bank_mask:0xf
    v_add_f32_dpp v69, v71, v69 row_ror:8 row_mask:0xf bank_mask:0xf
    v_add_f32_dpp v94, v51, v48 row_ror:4 row_mask:0xf bank_mask:0x1
    s_cbranch_vccnz L_w21
    s_waitcnt vmcnt(4)
L_w21:
    s_waitcnt vmcnt(6)
    buffer_load_dwordx4 v[120:123], v1, s[16:19], s48 offen nt
    v_add_f32_dpp v58, v56, v58 row_ror:8 row_mask:0xf bank_mask:0xf
    v_add_f32_dpp v95, v67, v64 row_ror:4 row_mask:0xf bank_mask:0x1
    v_add_f32_dpp v74, v72, v74 row_ror:8 row_mask:0xf bank_mask:0xf
    v_add_f32_dpp v94, v52, v53 row_ror:4 row_mask:0xf bank_mask:0x2
    v_add_f32_dpp v63, v61, v63 row_ror:8 row_mask:0xf bank_mask:0xf
    s_cbranch_vccnz L_w22
    s_waitcnt vmcnt(4)
L_w22:
    s_waitcnt vmcnt(5)
    buffer_load_dwordx4 v[124:127], v1, s[16:19], s49 offen nt
    v_add_f32_dpp v95, v68, v69 row_ror:4 row_mask:0xf bank_mask:0x2
    v_add_f32_dpp v79, v77, v79 row_ror:8 row_mask:0xf bank_mask:0xf
    s_nop 0
    v_add_f32_dpp v94, v57, v58 row_ror:4 row_mask:0xf bank_mask:0x4
    s_nop 0
    s_cbranch_vccnz L_w23
    s_waitcnt vmcnt(4)
L_w23:
    s_waitcnt vmcnt(5)
    buffer_load_dwordx4 v[128:131], v1, s[16:19], s50 offen nt
    v_add_f32_dpp v95, v73, v74 row_ror:4 row_mask:0xf bank_mask:0x4
    s_nop 0
    v_add_f32_dpp v94, v62, v63 row_ror:4 row_mask:0xf bank_mask:0x8
    s_nop 0
    v_add_f32_dpp v95, v78, v79 row_ror:4 row_mask:0xf bank_mask:0x8
    s_cbranch_vccnz L_w24
    s_waitcnt vmcnt(4)
L_w24:
    s_waitcnt vmcnt(5)
    buffer_load_dwordx4 v[132:135], v1, s[16:19], s51 offen nt
    ds_write_b32 v90, v94 offset:1024
    ds_write_b32 v90, v95 offset:1040
    v_max3_f32 v9, v94, v95, v9
    s_xor_b32 s39, s39, 0x8100
    s_xor_b32 s44, s39, s72
    s_xor_b32 s45, s39, s73
    s_xor_b32 s46, s39, s74
    s_xor_b32 s47, s39, s75
    s_xor_b32 s48, s39, s76
    s_xor_b32 s49, s39, s77
    s_xor_b32 s50, s39, s78
    s_xor_b32 s51, s39, s79
    s_waitcnt vmcnt(8)
    v_readfirstlane_b32 s52, v93
    s_bitcmp1_b32 s43, s36
    s_cselect_b32 s53, 1, 0
    s_nop 1
    s_mov_b64 vcc, s[52:53]
    v_mfma_f32_16x16x32_bf16 v[48:51], v[200:203], v[80:83], 0
    v_mfma_f32_16x16x32_bf16 v[52:55], v[204:207], v[80:83], 0
    s_cbranch_vccnz L_w25
    s_waitcnt vmcnt(4)
L_w25:
    s_waitcnt vmcnt(5)
    buffer_load_dwordx4 v[136:139], v1, s[16:19], s44 offen nt
    v_mfma_f32_16x16x32_bf16 v[56:59], v[208:211], v[80:83], 0
    v_mfma_f32_16x16x32_bf16 v[60:63], v[212:215], v[80:83], 0
    v_mfma_f32_16x16x32_bf16 v[64:67], v[216:219], v[80:83], 0
    v_mfma_f32_16x16x32_bf16 v[68:71], v[220:223], v[80:83], 0
    v_mfma_f32_16x16x32_bf16 v[72:75], v[224:227], v[80:83], 0
    s_cbranch_vccnz L_w26
    s_waitcnt vmcnt(4)
L_w26:
    s_waitcnt vmcnt(5)
    buffer_load_dwordx4 v[140:143], v1, s[16:19], s45 offen nt
    v_mfma_f32_16x16x32_bf16 v[76:79], v[228:231], v[80:83], 0
    s_nop 0
    v_add_f32_dpp v48, v49, v48 row_ror:12 row_mask:0xf bank_mask:0xf
    v_add_f32_dpp v53, v54, v53 row_ror:12 row_mask:0xf bank_mask:0xf
    v_add_f32_dpp v58, v59, v58 row_ror:12 row_mask:0xf bank_mask:0xf
    s_cbranch_vccnz L_w27
    s_waitcnt vmcnt(4)
L_w27:
    s_waitcnt vmcnt(5)
    buffer_load_dwordx4 v[144:147], v1, s[16:19], s46 offen nt
    v_add_f32_dpp v63, v60, v63 row_ror:12 row_mask:0xf bank_mask:0xf
    v_add_f32_dpp v64, v65, v64 row_ror:12 row_mask:0xf bank_mask:0xf
    v_add_f32_dpp v69, v70, v69 row_ror:12 row_mask:0xf bank_mask:0xf
    v_add_f32_dpp v74, v75, v74 row_ror:12 row_mask:0xf bank_mask:0xf
    v_add_f32_dpp v79, v76, v79 row_ror:12 row_mask:0xf bank_mask:0xf
    s_cbranch_vccnz L_w28
    s_waitcnt vmcnt(4)
L_w28:
    s_waitcnt vmcnt(5)
    buffer_load_dwordx4 v[148:151], v1, s[16:19], s47 offen nt
    v_add_f32_dpp v48, v50, v48 row_ror:8 row_mask:0xf bank_mask:0xf
    v_add_f32_dpp v64, v66, v64 row_ror:8 row_mask:0xf bank_mask:0xf
    v_add_f32_dpp v53, v55, v53 row_ror:8 row_mask:0xf bank_mask:0xf
    v_add_f32_dpp v69, v71, v69 row_ror:8 row_mask:0xf bank_mask:0xf
    v_add_f32_dpp v94, v51, v48 row_ror:4 row_mask:0xf bank_mask:0x1
    s_cbranch_vccnz L_w29
    s_waitcnt vmcnt(4)
L_w29:
    s_waitcnt vmcnt(5)
    buffer_load_dwordx4 v[152:155], v1, s[16:19], s48 offen nt
    v_add_f32_dpp v58, v56, v58 row_ror:8 row_mask:0xf bank_mask:0xf
    v_add_f32_dpp v95, v67, v64 row_ror:4 row_mask:0xf bank_mask:0x1
    v_add_f32_dpp v74, v72, v74 row_ror:8 row_mask:0xf bank_mask:0xf
    v_add_f32_dpp v94, v52, v53 row_ror:4 row_mask:0xf bank_mask:0x2
    v_add_f32_dpp v63, v61, v63 row_ror:8 row_mask:0xf bank_mask:0xf
    s_cbranch_vccnz L_w30
    s_waitcnt vmcnt(4)
L_w30:
    s_waitcnt vmcnt(5)
    buffer_load_dwordx4 v[156:159], v1, s[16:19], s49 offen nt
    v_add_f32_dpp v95, v68, v69 row_ror:4 row_mask:0xf bank_mask:0x2
    v_add_f32_dpp v79, v77, v79 row_ror:8 row_mask:0xf bank_mask:0xf
    s_nop 0
    v_add_f32_dpp v94, v57, v58 row_ror:4 row_mask:0xf bank_mask:0x4
    s_nop 0
    s_cbranch_vccnz L_w31
    s_waitcnt vmcnt(4)
L_w31:
    s_waitcnt vmcnt(5)
    buffer_load_dwordx4 v[160:163], v1, s[16:19], s50 offen nt
    v_add_f32_dpp v95, v73, v74 row_ror:4 row_mask:0xf bank_mask:0x4
    s_nop 0
    v_add_f32_dpp v94, v62, v63 row_ror:4 row_mask:0xf bank_mask:0x8
    s_nop 0
    v_add_f32_dpp v95, v78, v79 row_ror:4 row_mask:0xf bank_mask:0x8
    s_cbranch_vccnz L_w32
    s_waitcnt vmcnt(4)
L_w32:
    s_waitcnt vmcnt(5)
    buffer_load_dwordx4 v[164:167], v1, s[16:19], s51 offen nt
    ds_write_b32 v90, v94 offset:1536
    ds_write_b32 v90, v95 offset:1552
    v_max3_f32 v9, v94, v95, v9
    s_xor_b32 s39, s39, 0x48900
    s_xor_b32 s44, s39, s72
    s_xor_b32 s45, s39, s73
    s_xor_b32 s46, s39, s74
    s_xor_b32 s47, s39, s75
    s_xor_b32 s48, s39, s76
    s_xor_b32 s49, s39, s77
    s_xor_b32 s50, s39, s78
    s_xor_b32 s51, s39, s79
    v_add_u32 v90, 2048, v90
    v_add_u32 v232, 4, v232
    s_add_u32 s36, s36, 1
    s_cmp_lg_u32 s36, 8
    s_cbranch_scc1 L_kchk
    v_mov_b32 v10, v9
    s_nop 1
    v_permlane32_swap_b32 v9, v10
    v_max_f32 v9, v9, v10
    v_mov_b32 v10, v9
    s_nop 1
    v_permlane16_swap_b32 v9, v10
    v_max_f32 v9, v9, v10
    s_nop 1
    v_max_f32_dpp v9, v9, v9 row_ror:4 row_mask:0xf bank_mask:0xf
    s_nop 1
    v_max_f32_dpp v9, v9, v9 row_ror:8 row_mask:0xf bank_mask:0xf
    ds_write_b32 v89, v9 offset:128
    v_mov_b32 v6, 1
    ds_write_b32 v239, v6
    v_mov_b32 v80, v84
    v_mov_b32 v81, v85
    v_mov_b32 v82, v86
    v_mov_b32 v83, v87
    s_waitcnt lgkmcnt(1)
    v_mov_b32 v9, 0xff800000
L_kchk:
    s_cmp_lg_u32 s36, 12
    s_cbranch_scc1 L_kc2
L_p33:
    ds_read_b128 v[96:99], v238
    ds_read_b128 v[240:243], v237 offset:128
    s_waitcnt lgkmcnt(0)
    v_min3_u32 v96, v96, v97, v98
    v_min_u32 v96, v96, v99
    s_nop 0
    v_readfirstlane_b32 s37, v96
    s_nop 1
    s_cmp_lt_u32 s37, 1
    s_cbranch_scc1 L_p33
    v_max3_f32 v240, v240, v241, v242
    v_max_f32 v240, v240, v243
    v_mul_f32 v4, s33, v240
L_kc2:
    s_cmp_lt_u32 s36, 16
    s_cbranch_scc1 L_kloop
    v_mov_b32 v10, v9
    s_nop 1
    v_permlane32_swap_b32 v9, v10
    v_max_f32 v9, v9, v10
    v_mov_b32 v10, v9
    s_nop 1
    v_permlane16_swap_b32 v9, v10
    v_max_f32 v9, v9, v10
    s_nop 1
    v_max_f32_dpp v9, v9, v9 row_ror:4 row_mask:0xf bank_mask:0xf
    s_nop 1
    v_max_f32_dpp v9, v9, v9 row_ror:8 row_mask:0xf bank_mask:0xf
    ds_write_b32 v89, v9 offset:192
    v_mov_b32 v6, 2
    ds_write_b32 v239, v6
.p2align 6
L_vloop:
    s_waitcnt vmcnt(8)
    s_mov_b64 exec, 1
    global_store_dword v232, v233, s[12:13]
    s_mov_b64 exec, -1
    ds_read_b128 v[96:99], v91 offset:0
    ds_read_b128 v[100:103], v91 offset:16
    v_perm_b32 v48, v108, v104, s34
    v_perm_b32 v49, v116, v112, s34
    s_cbranch_vccnz L_w34
    s_waitcnt vmcnt(5)
L_w34:
    s_waitcnt vmcnt(6)
    buffer_load_dwordx4 v[168:171], v1, s[16:19], s44 offen nt
    v_perm_b32 v50, v124, v120, s34
    v_perm_b32 v51, v132, v128, s34
    v_perm_b32 v52, v108, v104, s35
    v_perm_b32 v53, v116, v112, s35
    v_perm_b32 v54, v124, v120, s35
    v_perm_b32 v55, v132, v128, s35
    v_perm_b32 v56, v109, v105, s34
    v_perm_b32 v57, v117, v113, s34
    v_perm_b32 v58, v125, v121, s34
    s_cbranch_vccnz L_w35
    s_waitcnt vmcnt(5)
L_w35:
    s_waitcnt vmcnt(6)
    buffer_load_dwordx4 v[172:175], v1, s[16:19], s45 offen nt
    v_perm_b32 v59, v133, v129, s34
    v_perm_b32 v60, v109, v105, s35
    v_perm_b32 v61, v117, v113, s35
    v_perm_b32 v62, v125, v121, s35
    v_perm_b32 v63, v133, v129, s35
    v_perm_b32 v64, v110, v106, s34
    v_perm_b32 v65, v118, v114, s34
    v_perm_b32 v66, v126, v122, s34
    v_perm_b32 v67, v134, v130, s34
    s_cbranch_vccnz L_w36
    s_waitcnt vmcnt(5)
L_w36:
    s_waitcnt vmcnt(6)
    buffer_load_dwordx4 v[176:179], v1, s[16:19], s46 offen nt
    v_perm_b32 v68, v110, v106, s35
    v_perm_b32 v69, v118, v114, s35
    v_perm_b32 v70, v126, v122, s35
    v_perm_b32 v71, v134, v130, s35
    v_perm_b32 v72, v111, v107, s34
    v_perm_b32 v73, v119, v115, s34
    v_perm_b32 v74, v127, v123, s34
    v_perm_b32 v75, v135, v131, s34
    v_perm_b32 v76, v111, v107, s35
    s_cbranch_vccnz L_w37
    s_waitcnt vmcnt(5)
L_w37:
    s_waitcnt vmcnt(6)
    buffer_load_dwordx4 v[180:183], v1, s[16:19], s47 offen nt
    v_perm_b32 v77, v119, v115, s35
    v_perm_b32 v78, v127, v123, s35
    v_perm_b32 v79, v135, v131, s35
    s_waitcnt lgkmcnt(0)
    v_fma_f32 v96, v96, s33, -v4
    v_fma_f32 v97, v97, s33, -v4
    v_fma_f32 v98, v98, s33, -v4
    v_fma_f32 v99, v99, s33, -v4
    v_fma_f32 v100, v100, s33, -v4
    s_cbranch_vccnz L_w38
    s_waitcnt vmcnt(4)
L_w38:
    s_waitcnt vmcnt(6)
    buffer_load_dwordx4 v[184:187], v1, s[16:19], s48 offen nt
    v_fma_f32 v101, v101, s33, -v4
    v_fma_f32 v102, v102, s33, -v4
    v_fma_f32 v103, v103, s33, -v4
    v_exp_f32 v96, v96
    v_exp_f32 v97, v97
    v_exp_f32 v98, v98
    v_exp_f32 v99, v99
    v_exp_f32 v100, v100
    v_exp_f32 v101, v101
    s_cbranch_vccnz L_w39
    s_waitcnt vmcnt(4)
L_w39:
    s_waitcnt vmcnt(5)
    buffer_load_dwordx4 v[188:191], v1, s[16:19], s49 offen nt
    v_exp_f32 v102, v102
    v_exp_f32 v103, v103
    s_nop 0
    v_cvt_pk_bf16_f32 v12, v96, v97
    v_cvt_pk_bf16_f32 v13, v98, v99
    v_cvt_pk_bf16_f32 v14, v100, v101
    v_cvt_pk_bf16_f32 v15, v102, v103
    v_add_f32 v8, v96, v97
    v_add_f32 v10, v98, v99
    s_cbranch_vccnz L_w40
    s_waitcnt vmcnt(4)
L_w40:
    s_waitcnt vmcnt(5)
    buffer_load_dwordx4 v[192:195], v1, s[16:19], s50 offen nt
    v_mfma_f32_16x16x32_bf16 v[16:19], v[48:51], v[12:15], v[16:19]
    v_add_f32 v11, v100, v101
    v_mfma_f32_16x16x32_bf16 v[20:23], v[52:55], v[12:15], v[20:23]
    v_add_f32 v5, v5, v102
    v_mfma_f32_16x16x32_bf16 v[24:27], v[56:59], v[12:15], v[24:27]
    v_add_f32 v8, v8, v103
    v_mfma_f32_16x16x32_bf16 v[28:31], v[60:63], v[12:15], v[28:31]
    v_add_f32 v10, v10, v11
    v_mfma_f32_16x16x32_bf16 v[32:35], v[64:67], v[12:15], v[32:35]
    s_cbranch_vccnz L_w41
    s_waitcnt vmcnt(4)
L_w41:
    s_waitcnt vmcnt(5)
    buffer_load_dwordx4 v[196:199], v1, s[16:19], s51 offen nt
    v_add_f32 v5, v5, v8
    v_mfma_f32_16x16x32_bf16 v[36:39], v[68:71], v[12:15], v[36:39]
    v_add_f32 v5, v5, v10
    v_mfma_f32_16x16x32_bf16 v[40:43], v[72:75], v[12:15], v[40:43]
    v_mfma_f32_16x16x32_bf16 v[44:47], v[76:79], v[12:15], v[44:47]
    s_xor_b32 s39, s39, 0x8100
    s_xor_b32 s44, s39, s72
    s_xor_b32 s45, s39, s73
    s_xor_b32 s46, s39, s74
    s_xor_b32 s47, s39, s75
    s_xor_b32 s48, s39, s76
    s_xor_b32 s49, s39, s77
    s_xor_b32 s50, s39, s78
    s_xor_b32 s51, s39, s79
    s_waitcnt vmcnt(8)
    ds_read_b128 v[96:99], v91 offset:512
    ds_read_b128 v[100:103], v91 offset:528
    v_perm_b32 v48, v140, v136, s34
    v_perm_b32 v49, v148, v144, s34
    s_cbranch_vccnz L_w42
    s_waitcnt vmcnt(4)
L_w42:
    s_waitcnt vmcnt(5)
    buffer_load_dwordx4 v[200:203], v1, s[16:19], s44 offen nt
    v_perm_b32 v50, v156, v152, s34
    v_perm_b32 v51, v164, v160, s34
    v_perm_b32 v52, v140, v136, s35
    v_perm_b32 v53, v148, v144, s35
    v_perm_b32 v54, v156, v152, s35
    v_perm_b32 v55, v164, v160, s35
    v_perm_b32 v56, v141, v137, s34
    v_perm_b32 v57, v149, v145, s34
    v_perm_b32 v58, v157, v153, s34
    s_cbranch_vccnz L_w43
    s_waitcnt vmcnt(4)
L_w43:
    s_waitcnt vmcnt(5)
    buffer_load_dwordx4 v[204:207], v1, s[16:19], s45 offen nt
    v_perm_b32 v59, v165, v161, s34
    v_perm_b32 v60, v141, v137, s35
    v_perm_b32 v61, v149, v145, s35
    v_perm_b32 v62, v157, v153, s35
    v_perm_b32 v63, v165, v161, s35
    v_perm_b32 v64, v142, v138, s34
    v_perm_b32 v65, v150, v146, s34
    v_perm_b32 v66, v158, v154, s34
    v_perm_b32 v67, v166, v162, s34
    s_cbranch_vccnz L_w44
    s_waitcnt vmcnt(4)
L_w44:
    s_waitcnt vmcnt(5)
    buffer_load_dwordx4 v[208:211], v1, s[16:19], s46 offen nt
    v_perm_b32 v68, v142, v138, s35
    v_perm_b32 v69, v150, v146, s35
    v_perm_b32 v70, v158, v154, s35
    v_perm_b32 v71, v166, v162, s35
    v_perm_b32 v72, v143, v139, s34
    v_perm_b32 v73, v151, v147, s34
    v_perm_b32 v74, v159, v155, s34
    v_perm_b32 v75, v167, v163, s34
    v_perm_b32 v76, v143, v139, s35
    s_cbranch_vccnz L_w45
    s_waitcnt vmcnt(4)
L_w45:
    s_waitcnt vmcnt(5)
    buffer_load_dwordx4 v[212:215], v1, s[16:19], s47 offen nt
    v_perm_b32 v77, v151, v147, s35
    v_perm_b32 v78, v159, v155, s35
    v_perm_b32 v79, v167, v163, s35
    s_waitcnt lgkmcnt(0)
    v_fma_f32 v96, v96, s33, -v4
    v_fma_f32 v97, v97, s33, -v4
    v_fma_f32 v98, v98, s33, -v4
    v_fma_f32 v99, v99, s33, -v4
    v_fma_f32 v100, v100, s33, -v4
    s_cbranch_vccnz L_w46
    s_waitcnt vmcnt(4)
L_w46:
    s_waitcnt vmcnt(5)
    buffer_load_dwordx4 v[216:219], v1, s[16:19], s48 offen nt
    v_fma_f32 v101, v101, s33, -v4
    v_fma_f32 v102, v102, s33, -v4
    v_fma_f32 v103, v103, s33, -v4
    v_exp_f32 v96, v96
    v_exp_f32 v97, v97
    v_exp_f32 v98, v98
    v_exp_f32 v99, v99
    v_exp_f32 v100, v100
    v_exp_f32 v101, v101
    s_cbranch_vccnz L_w47
    s_waitcnt vmcnt(4)
L_w47:
    s_waitcnt vmcnt(5)
    buffer_load_dwordx4 v[220:223], v1, s[16:19], s49 offen nt
    v_exp_f32 v102, v102
    v_exp_f32 v103, v103
    s_nop 0
    v_cvt_pk_bf16_f32 v12, v96, v97
    v_cvt_pk_bf16_f32 v13, v98, v99
    v_cvt_pk_bf16_f32 v14, v100, v101
    v_cvt_pk_bf16_f32 v15, v102, v103
    v_add_f32 v8, v96, v97
    v_add_f32 v10, v98, v99
    s_cbranch_vccnz L_w48
    s_waitcnt vmcnt(4)
L_w48:
    s_waitcnt vmcnt(5)
    buffer_load_dwordx4 v[224:227], v1, s[16:19], s50 offen nt
    v_mfma_f32_16x16x32_bf16 v[16:19], v[48:51], v[12:15], v[16:19]
    v_add_f32 v11, v100, v101
    v_mfma_f32_16x16x32_bf16 v[20:23], v[52:55], v[12:15], v[20:23]
    v_add_f32 v5, v5, v102
    v_mfma_f32_16x16x32_bf16 v[24:27], v[56:59], v[12:15], v[24:27]
    v_add_f32 v8, v8, v103
    v_mfma_f32_16x16x32_bf16 v[28:31], v[60:63], v[12:15], v[28:31]
    v_add_f32 v10, v10, v11
    v_mfma_f32_16x16x32_bf16 v[32:35], v[64:67], v[12:15], v[32:35]
    s_cbranch_vccnz L_w49
    s_waitcnt vmcnt(4)
L_w49:
    s_waitcnt vmcnt(5)
    buffer_load_dwordx4 v[228:231], v1, s[16:19], s51 offen nt
    v_add_f32 v5, v5, v8
    v_mfma_f32_16x16x32_bf16 v[36:39], v[68:71], v[12:15], v[36:39]
    v_add_f32 v5, v5, v10
    v_mfma_f32_16x16x32_bf16 v[40:43], v[72:75], v[12:15], v[40:43]
    v_mfma_f32_16x16x32_bf16 v[44:47], v[76:79], v[12:15], v[44:47]
    s_add_u32 s38, s36, 1
    s_bitcmp1_b32 s38, 0
    s_cselect_b32 s39, 0x20000, 0
    s_bitcmp1_b32 s38, 1
    s_cselect_b32 s37, 0x84000, 0
    s_xor_b32 s39, s39, s37
    s_bitcmp1_b32 s38, 2
    s_cselect_b32 s37, 0x100, 0
    s_xor_b32 s39, s39, s37
    s_bitcmp1_b32 s38, 3
    s_cselect_b32 s37, 0x100000, 0
    s_xor_b32 s39, s39, s37
    s_xor_b32 s44, s39, s72
    s_xor_b32 s45, s39, s73
    s_xor_b32 s46, s39, s74
    s_xor_b32 s47, s39, s75
    s_xor_b32 s48, s39, s76
    s_xor_b32 s49, s39, s77
    s_xor_b32 s50, s39, s78
    s_xor_b32 s51, s39, s79
    s_waitcnt vmcnt(8)
    s_mov_b64 exec, 1
    global_load_dword v93, v232, s[12:13] offset:4 sc1
    s_mov_b64 exec, -1
    ds_read_b128 v[96:99], v91 offset:1024
    ds_read_b128 v[100:103], v91 offset:1040
    v_perm_b32 v48, v172, v168, s34
    v_perm_b32 v49, v180, v176, s34
    s_cbranch_vccnz L_w50
    s_waitcnt vmcnt(5)
L_w50:
    s_waitcnt vmcnt(6)
    buffer_load_dwordx4 v[104:107], v1, s[16:19], s44 offen nt
    v_perm_b32 v50, v188, v184, s34
    v_perm_b32 v51, v196, v192, s34
    v_perm_b32 v52, v172, v168, s35
    v_perm_b32 v53, v180, v176, s35
    v_perm_b32 v54, v188, v184, s35
    v_perm_b32 v55, v196, v192, s35
    v_perm_b32 v56, v173, v169, s34
    v_perm_b32 v57, v181, v177, s34
    v_perm_b32 v58, v189, v185, s34
    s_cbranch_vccnz L_w51
    s_waitcnt vmcnt(5)
L_w51:
    s_waitcnt vmcnt(6)
    buffer_load_dwordx4 v[108:111], v1, s[16:19], s45 offen nt
    v_perm_b32 v59, v197, v193, s34
    v_perm_b32 v60, v173, v169, s35
    v_perm_b32 v61, v181, v177, s35
    v_perm_b32 v62, v189, v185, s35
    v_perm_b32 v63, v197, v193, s35
    v_perm_b32 v64, v174, v170, s34
    v_perm_b32 v65, v182, v178, s34
    v_perm_b32 v66, v190, v186, s34
    v_perm_b32 v67, v198, v194, s34
    s_cbranch_vccnz L_w52
    s_waitcnt vmcnt(5)
L_w52:
    s_waitcnt vmcnt(6)
    buffer_load_dwordx4 v[112:115], v1, s[16:19], s46 offen nt
    v_perm_b32 v68, v174, v170, s35
    v_perm_b32 v69, v182, v178, s35
    v_perm_b32 v70, v190, v186, s35
    v_perm_b32 v71, v198, v194, s35
    v_perm_b32 v72, v175, v171, s34
    v_perm_b32 v73, v183, v179, s34
    v_perm_b32 v74, v191, v187, s34
    v_perm_b32 v75, v199, v195, s34
    v_perm_b32 v76, v175, v171, s35
    s_cbranch_vccnz L_w53
    s_waitcnt vmcnt(5)
L_w53:
    s_waitcnt vmcnt(6)
    buffer_load_dwordx4 v[116:119], v1, s[16:19], s47 offen nt
    v_perm_b32 v77, v183, v179, s35
    v_perm_b32 v78, v191, v187, s35
    v_perm_b32 v79, v199, v195, s35
    s_waitcnt lgkmcnt(0)
    v_fma_f32 v96, v96, s33, -v4
    v_fma_f32 v97, v97, s33, -v4
    v_fma_f32 v98, v98, s33, -v4
    v_fma_f32 v99, v99, s33, -v4
    v_fma_f32 v100, v100, s33, -v4
    s_cbranch_vccnz L_w54
    s_waitcnt vmcnt(4)
L_w54:
    s_waitcnt vmcnt(6)
    buffer_load_dwordx4 v[120:123], v1, s[16:19], s48 offen nt
    v_fma_f32 v101, v101, s33, -v4
    v_fma_f32 v102, v102, s33, -v4
    v_fma_f32 v103, v103, s33, -v4
    v_exp_f32 v96, v96
    v_exp_f32 v97, v97
    v_exp_f32 v98, v98
    v_exp_f32 v99, v99
    v_exp_f32 v100, v100
    v_exp_f32 v101, v101
    s_cbranch_vccnz L_w55
    s_waitcnt vmcnt(4)
L_w55:
    s_waitcnt vmcnt(5)
    buffer_load_dwordx4 v[124:127], v1, s[16:19], s49 offen nt
    v_exp_f32 v102, v102
    v_exp_f32 v103, v103
    s_nop 0
    v_cvt_pk_bf16_f32 v12, v96, v97
    v_cvt_pk_bf16_f32 v13, v98, v99
    v_cvt_pk_bf16_f32 v14, v100, v101
    v_cvt_pk_bf16_f32 v15, v102, v103
    v_add_f32 v8, v96, v97
    v_add_f32 v10, v98, v99
    s_cbranch_vccnz L_w56
    s_waitcnt vmcnt(4)
L_w56:
    s_waitcnt vmcnt(5)
    buffer_load_dwordx4 v[128:131], v1, s[16:19], s50 offen nt
    v_mfma_f32_16x16x32_bf16 v[16:19], v[48:51], v[12:15], v[16:19]
    v_add_f32 v11, v100, v101
    v_mfma_f32_16x16x32_bf16 v[20:23], v[52:55], v[12:15], v[20:23]
    v_add_f32 v5, v5, v102
    v_mfma_f32_16x16x32_bf16 v[24:27], v[56:59], v[12:15], v[24:27]
    v_add_f32 v8, v8, v103
    v_mfma_f32_16x16x32_bf16 v[28:31], v[60:63], v[12:15], v[28:31]
    v_add_f32 v10, v10, v11
    v_mfma_f32_16x16x32_bf16 v[32:35], v[64:67], v[12:15], v[32:35]
    s_cbranch_vccnz L_w57
    s_waitcnt vmcnt(4)
L_w57:
    s_waitcnt vmcnt(5)
    buffer_load_dwordx4 v[132:135], v1, s[16:19], s51 offen nt
    v_add_f32 v5, v5, v8
    v_mfma_f32_16x16x32_bf16 v[36:39], v[68:71], v[12:15], v[36:39]
    v_add_f32 v5, v5, v10
    v_mfma_f32_16x16x32_bf16 v[40:43], v[72:75], v[12:15], v[40:43]
    v_mfma_f32_16x16x32_bf16 v[44:47], v[76:79], v[12:15], v[44:47]
    s_xor_b32 s39, s39, 0x8100
    s_xor_b32 s44, s39, s72
    s_xor_b32 s45, s39, s73
    s_xor_b32 s46, s39, s74
    s_xor_b32 s47, s39, s75
    s_xor_b32 s48, s39, s76
    s_xor_b32 s49, s39, s77
    s_xor_b32 s50, s39, s78
    s_xor_b32 s51, s39, s79
    s_waitcnt vmcnt(8)
    v_readfirstlane_b32 s52, v93
    s_bitcmp1_b32 s43, s36
    s_cselect_b32 s53, 1, 0
    s_nop 1
    s_mov_b64 vcc, s[52:53]
    ds_read_b128 v[96:99], v91 offset:1536
    ds_read_b128 v[100:103], v91 offset:1552
    v_perm_b32 v48, v204, v200, s34
    v_perm_b32 v49, v212, v208, s34
    s_cbranch_vccnz L_w58
    s_waitcnt vmcnt(4)
L_w58:
    s_waitcnt vmcnt(5)
    buffer_load_dwordx4 v[136:139], v1, s[16:19], s44 offen nt
    v_perm_b32 v50, v220, v216, s34
    v_perm_b32 v51, v228, v224, s34
    v_perm_b32 v52, v204, v200, s35
    v_perm_b32 v53, v212, v208, s35
    v_perm_b32 v54, v220, v216, s35
    v_perm_b32 v55, v228, v224, s35
    v_perm_b32 v56, v205, v201, s34
    v_perm_b32 v57, v213, v209, s34
    v_perm_b32 v58, v221, v217, s34
    s_cbranch_vccnz L_w59
    s_waitcnt vmcnt(4)
L_w59:
    s_waitcnt vmcnt(5)
    buffer_load_dwordx4 v[140:143], v1, s[16:19], s45 offen nt
    v_perm_b32 v59, v229, v225, s34
    v_perm_b32 v60, v205, v201, s35
    v_perm_b32 v61, v213, v209, s35
    v_perm_b32 v62, v221, v217, s35
    v_perm_b32 v63, v229, v225, s35
    v_perm_b32 v64, v206, v202, s34
    v_perm_b32 v65, v214, v210, s34
    v_perm_b32 v66, v222, v218, s34
    v_perm_b32 v67, v230, v226, s34
    s_cbranch_vccnz L_w60
    s_waitcnt vmcnt(4)
L_w60:
    s_waitcnt vmcnt(5)
    buffer_load_dwordx4 v[144:147], v1, s[16:19], s46 offen nt
    v_perm_b32 v68, v206, v202, s35
    v_perm_b32 v69, v214, v210, s35
    v_perm_b32 v70, v222, v218, s35
    v_perm_b32 v71, v230, v226, s35
    v_perm_b32 v72, v207, v203, s34
    v_perm_b32 v73, v215, v211, s34
    v_perm_b32 v74, v223, v219, s34
    v_perm_b32 v75, v231, v227, s34
    v_perm_b32 v76, v207, v203, s35
    s_cbranch_vccnz L_w61
    s_waitcnt vmcnt(4)
L_w61:
    s_waitcnt vmcnt(5)
    buffer_load_dwordx4 v[148:151], v1, s[16:19], s47 offen nt
    v_perm_b32 v77, v215, v211, s35
    v_perm_b32 v78, v223, v219, s35
    v_perm_b32 v79, v231, v227, s35
    s_waitcnt lgkmcnt(0)
    v_fma_f32 v96, v96, s33, -v4
    v_fma_f32 v97, v97, s33, -v4
    v_fma_f32 v98, v98, s33, -v4
    v_fma_f32 v99, v99, s33, -v4
    v_fma_f32 v100, v100, s33, -v4
    s_cbranch_vccnz L_w62
    s_waitcnt vmcnt(4)
L_w62:
    s_waitcnt vmcnt(5)
    buffer_load_dwordx4 v[152:155], v1, s[16:19], s48 offen nt
    v_fma_f32 v101, v101, s33, -v4
    v_fma_f32 v102, v102, s33, -v4
    v_fma_f32 v103, v103, s33, -v4
    v_exp_f32 v96, v96
    v_exp_f32 v97, v97
    v_exp_f32 v98, v98
    v_exp_f32 v99, v99
    v_exp_f32 v100, v100
    v_exp_f32 v101, v101
    s_cbranch_vccnz L_w63
    s_waitcnt vmcnt(4)
L_w63:
    s_waitcnt vmcnt(5)
    buffer_load_dwordx4 v[156:159], v1, s[16:19], s49 offen nt
    v_exp_f32 v102, v102
    v_exp_f32 v103, v103
    s_nop 0
    v_cvt_pk_bf16_f32 v12, v96, v97
    v_cvt_pk_bf16_f32 v13, v98, v99
    v_cvt_pk_bf16_f32 v14, v100, v101
    v_cvt_pk_bf16_f32 v15, v102, v103
    v_add_f32 v8, v96, v97
    v_add_f32 v10, v98, v99
    s_cbranch_vccnz L_w64
    s_waitcnt vmcnt(4)
L_w64:
    s_waitcnt vmcnt(5)
    buffer_load_dwordx4 v[160:163], v1, s[16:19], s50 offen nt
    v_mfma_f32_16x16x32_bf16 v[16:19], v[48:51], v[12:15], v[16:19]
    v_add_f32 v11, v100, v101
    v_mfma_f32_16x16x32_bf16 v[20:23], v[52:55], v[12:15], v[20:23]
    v_add_f32 v5, v5, v102
    v_mfma_f32_16x16x32_bf16 v[24:27], v[56:59], v[12:15], v[24:27]
    v_add_f32 v8, v8, v103
    v_mfma_f32_16x16x32_bf16 v[28:31], v[60:63], v[12:15], v[28:31]
    v_add_f32 v10, v10, v11
    v_mfma_f32_16x16x32_bf16 v[32:35], v[64:67], v[12:15], v[32:35]
    s_cbranch_vccnz L_w65
    s_waitcnt vmcnt(4)
L_w65:
    s_waitcnt vmcnt(5)
    buffer_load_dwordx4 v[164:167], v1, s[16:19], s51 offen nt
    v_add_f32 v5, v5, v8
    v_mfma_f32_16x16x32_bf16 v[36:39], v[68:71], v[12:15], v[36:39]
    v_add_f32 v5, v5, v10
    v_mfma_f32_16x16x32_bf16 v[40:43], v[72:75], v[12:15], v[40:43]
    v_mfma_f32_16x16x32_bf16 v[44:47], v[76:79], v[12:15], v[44:47]
    s_xor_b32 s39, s39, 0x48900
    s_xor_b32 s44, s39, s72
    s_xor_b32 s45, s39, s73
    s_xor_b32 s46, s39, s74
    s_xor_b32 s47, s39, s75
    s_xor_b32 s48, s39, s76
    s_xor_b32 s49, s39, s77
    s_xor_b32 s50, s39, s78
    s_xor_b32 s51, s39, s79
    v_add_u32 v91, 2048, v91
    v_add_u32 v232, 4, v232
    s_add_u32 s36, s36, 1
    s_cmp_lg_u32 s36, 24
    s_cbranch_scc1 L_vc1
    v_mov_b32 v10, v5
    s_nop 1
    v_permlane32_swap_b32 v5, v10
    v_add_f32 v5, v5, v10
    v_mov_b32 v10, v5
    s_nop 1
    v_permlane16_swap_b32 v5, v10
    v_add_f32 v5, v5, v10
    ds_write_b32 v89, v5 offset:0
    s_mov_b32 exec_lo, 0x000f000f
    s_mov_b32 exec_hi, 0x000f000f
    ds_write_b128 v88, v[16:19] offset:0
    ds_write_b128 v88, v[20:23] offset:16
    ds_write_b128 v88, v[24:27] offset:32
    ds_write_b128 v88, v[28:31] offset:48
    ds_write_b128 v88, v[32:35] offset:64
    ds_write_b128 v88, v[36:39] offset:80
    ds_write_b128 v88, v[40:43] offset:96
    ds_write_b128 v88, v[44:47] offset:112
    s_mov_b64 exec, -1
    v_mov_b32 v6, 3
    ds_write_b32 v239, v6
    v_mov_b32 v4, v9
    s_waitcnt lgkmcnt(1)
    v_mov_b32 v16, 0
    v_mov_b32 v17, 0
    v_mov_b32 v18, 0
    v_mov_b32 v19, 0
    v_mov_b32 v20, 0
    v_mov_b32 v21, 0
    v_mov_b32 v22, 0
    v_mov_b32 v23, 0
    v_mov_b32 v24, 0
    v_mov_b32 v25, 0
    v_mov_b32 v26, 0
    v_mov_b32 v27, 0
    v_mov_b32 v28, 0
    v_mov_b32 v29, 0
    v_mov_b32 v30, 0
    v_mov_b32 v31, 0
    v_mov_b32 v32, 0
    v_mov_b32 v33, 0
    v_mov_b32 v34, 0
    v_mov_b32 v35, 0
    v_mov_b32 v36, 0
    v_mov_b32 v37, 0
    v_mov_b32 v38, 0
    v_mov_b32 v39, 0
    v_mov_b32 v40, 0
    v_mov_b32 v41, 0
    v_mov_b32 v42, 0
    v_mov_b32 v43, 0
    v_mov_b32 v44, 0
    v_mov_b32 v45, 0
    v_mov_b32 v46, 0
    v_mov_b32 v47, 0
    v_mov_b32 v5, 0
L_vc1:
    s_cmp_lg_u32 s36, 20
    s_cbranch_scc1 L_vc3
L_p66:
    ds_read_b128 v[96:99], v238
    ds_read_b128 v[240:243], v237 offset:192
    s_waitcnt lgkmcnt(0)
    v_min3_u32 v96, v96, v97, v98
    v_min_u32 v96, v96, v99
    s_nop 0
    v_readfirstlane_b32 s37, v96
    s_nop 1
    s_cmp_lt_u32 s37, 2
    s_cbranch_scc1 L_p66
    v_max3_f32 v240, v240, v241, v242
    v_max_f32 v240, v240, v243
    v_mul_f32 v9, s33, v240
L_vc3:
    s_cmp_lg_u32 s36, 28
    s_cbranch_scc1 L_vc2
L_p67:
    ds_read_b128 v[96:99], v238
    ds_read_b128 v[240:243], v235 offset:0
    ds_read_b32 v244, v234 offset:0
    ds_read_b32 v245, v234 offset:16
    ds_read_b32 v246, v234 offset:2048
    ds_read_b32 v247, v234 offset:2064
    ds_read_b32 v248, v234 offset:4096
    ds_read_b32 v249, v234 offset:4112
    ds_read_b32 v250, v234 offset:6144
    ds_read_b32 v251, v234 offset:6160
    s_waitcnt lgkmcnt(0)
    v_min3_u32 v96, v96, v97, v98
    v_min_u32 v96, v96, v99
    s_nop 0
    v_readfirstlane_b32 s37, v96
    s_nop 1
    s_cmp_lt_u32 s37, 3
    s_cbranch_scc1 L_p67
    s_waitcnt lgkmcnt(8)
    v_add_f32 v240, v240, v241
    v_add_f32 v242, v242, v243
    v_add_f32 v240, v240, v242
    v_rcp_f32 v240, v240
    s_waitcnt lgkmcnt(4)
    v_add_f32 v244, v244, v246
    v_add_f32 v245, v245, v247
    s_waitcnt lgkmcnt(0)
    v_add_f32 v248, v248, v250
    v_add_f32 v249, v249, v251
    v_add_f32 v244, v244, v248
    v_add_f32 v245, v245, v249
    v_mul_f32 v244, v244, v240
    v_mul_f32 v245, v245, v240
    v_cvt_pk_bf16_f32 v252, v244, v245
    buffer_store_dword v252, v236, s[28:31], s40 offen
L_vc2:
    s_cmp_lt_u32 s36, 31
    s_cbranch_scc1 L_vloop
    s_waitcnt vmcnt(8)
    s_mov_b64 exec, 1
    global_store_dword v232, v233, s[12:13]
    s_mov_b64 exec, -1
    ds_read_b128 v[96:99], v91 offset:0
    ds_read_b128 v[100:103], v91 offset:16
    v_perm_b32 v48, v108, v104, s34
    v_perm_b32 v49, v116, v112, s34
    s_waitcnt vmcnt(12)
    buffer_load_dwordx4 v[168:171], v1, s[16:19], s44 offen nt
    v_perm_b32 v50, v124, v120, s34
    v_perm_b32 v51, v132, v128, s34
    v_perm_b32 v52, v108, v104, s35
    v_perm_b32 v53, v116, v112, s35
    v_perm_b32 v54, v124, v120, s35
    v_perm_b32 v55, v132, v128, s35
    v_perm_b32 v56, v109, v105, s34
    v_perm_b32 v57, v117, v113, s34
    v_perm_b32 v58, v125, v121, s34
    s_waitcnt vmcnt(12)
    buffer_load_dwordx4 v[172:175], v1, s[16:19], s45 offen nt
    v_perm_b32 v59, v133, v129, s34
    v_perm_b32 v60, v109, v105, s35
    v_perm_b32 v61, v117, v113, s35
    v_perm_b32 v62, v125, v121, s35
    v_perm_b32 v63, v133, v129, s35
    v_perm_b32 v64, v110, v106, s34
    v_perm_b32 v65, v118, v114, s34
    v_perm_b32 v66, v126, v122, s34
    v_perm_b32 v67, v134, v130, s34
    s_waitcnt vmcnt(12)
    buffer_load_dwordx4 v[176:179], v1, s[16:19], s46 offen nt
    v_perm_b32 v68, v110, v106, s35
    v_perm_b32 v69, v118, v114, s35
    v_perm_b32 v70, v126, v122, s35
    v_perm_b32 v71, v134, v130, s35
    v_perm_b32 v72, v111, v107, s34
    v_perm_b32 v73, v119, v115, s34
    v_perm_b32 v74, v127, v123, s34
    v_perm_b32 v75, v135, v131, s34
    v_perm_b32 v76, v111, v107, s35
    s_waitcnt vmcnt(12)
    buffer_load_dwordx4 v[180:183], v1, s[16:19], s47 offen nt
    v_perm_b32 v77, v119, v115, s35
    v_perm_b32 v78, v127, v123, s35
    v_perm_b32 v79, v135, v131, s35
    s_waitcnt lgkmcnt(0)
    v_fma_f32 v96, v96, s33, -v4
    v_fma_f32 v97, v97, s33, -v4
    v_fma_f32 v98, v98, s33, -v4
    v_fma_f32 v99, v99, s33, -v4
    v_fma_f32 v100, v100, s33, -v4
    s_waitcnt vmcnt(12)
    buffer_load_dwordx4 v[184:187], v1, s[16:19], s48 offen nt
    v_fma_f32 v101, v101, s33, -v4
    v_fma_f32 v102, v102, s33, -v4
    v_fma_f32 v103, v103, s33, -v4
    v_exp_f32 v96, v96
    v_exp_f32 v97, v97
    v_exp_f32 v98, v98
    v_exp_f32 v99, v99
    v_exp_f32 v100, v100
    v_exp_f32 v101, v101
    s_waitcnt vmcnt(12)
    buffer_load_dwordx4 v[188:191], v1, s[16:19], s49 offen nt
    v_exp_f32 v102, v102
    v_exp_f32 v103, v103
    s_nop 0
    v_cvt_pk_bf16_f32 v12, v96, v97
    v_cvt_pk_bf16_f32 v13, v98, v99
    v_cvt_pk_bf16_f32 v14, v100, v101
    v_cvt_pk_bf16_f32 v15, v102, v103
    v_add_f32 v8, v96, v97
    v_add_f32 v10, v98, v99
    s_waitcnt vmcnt(12)
    buffer_load_dwordx4 v[192:195], v1, s[16:19], s50 offen nt
    v_mfma_f32_16x16x32_bf16 v[16:19], v[48:51], v[12:15], v[16:19]
    v_add_f32 v11, v100, v101
    v_mfma_f32_16x16x32_bf16 v[20:23], v[52:55], v[12:15], v[20:23]
    v_add_f32 v5, v5, v102
    v_mfma_f32_16x16x32_bf16 v[24:27], v[56:59], v[12:15], v[24:27]
    v_add_f32 v8, v8, v103
    v_mfma_f32_16x16x32_bf16 v[28:31], v[60:63], v[12:15], v[28:31]
    v_add_f32 v10, v10, v11
    v_mfma_f32_16x16x32_bf16 v[32:35], v[64:67], v[12:15], v[32:35]
    s_waitcnt vmcnt(12)
    buffer_load_dwordx4 v[196:199], v1, s[16:19], s51 offen nt
    v_add_f32 v5, v5, v8
    v_mfma_f32_16x16x32_bf16 v[36:39], v[68:71], v[12:15], v[36:39]
    v_add_f32 v5, v5, v10
    v_mfma_f32_16x16x32_bf16 v[40:43], v[72:75], v[12:15], v[40:43]
    v_mfma_f32_16x16x32_bf16 v[44:47], v[76:79], v[12:15], v[44:47]
    s_xor_b32 s39, s39, 0x8100
    s_xor_b32 s44, s39, s72
    s_xor_b32 s45, s39, s73
    s_xor_b32 s46, s39, s74
    s_xor_b32 s47, s39, s75
    s_xor_b32 s48, s39, s76
    s_xor_b32 s49, s39, s77
    s_xor_b32 s50, s39, s78
    s_xor_b32 s51, s39, s79
    s_waitcnt vmcnt(8)
    ds_read_b128 v[96:99], v91 offset:512
    ds_read_b128 v[100:103], v91 offset:528
    v_perm_b32 v48, v140, v136, s34
    v_perm_b32 v49, v148, v144, s34
    s_waitcnt vmcnt(11)
    buffer_load_dwordx4 v[200:203], v1, s[16:19], s44 offen nt
    v_perm_b32 v50, v156, v152, s34
    v_perm_b32 v51, v164, v160, s34
    v_perm_b32 v52, v140, v136, s35
    v_perm_b32 v53, v148, v144, s35
    v_perm_b32 v54, v156, v152, s35
    v_perm_b32 v55, v164, v160, s35
    v_perm_b32 v56, v141, v137, s34
    v_perm_b32 v57, v149, v145, s34
    v_perm_b32 v58, v157, v153, s34
    s_waitcnt vmcnt(11)
    buffer_load_dwordx4 v[204:207], v1, s[16:19], s45 offen nt
    v_perm_b32 v59, v165, v161, s34
    v_perm_b32 v60, v141, v137, s35
    v_perm_b32 v61, v149, v145, s35
    v_perm_b32 v62, v157, v153, s35
    v_perm_b32 v63, v165, v161, s35
    v_perm_b32 v64, v142, v138, s34
    v_perm_b32 v65, v150, v146, s34
    v_perm_b32 v66, v158, v154, s34
    v_perm_b32 v67, v166, v162, s34
    s_waitcnt vmcnt(11)
    buffer_load_dwordx4 v[208:211], v1, s[16:19], s46 offen nt
    v_perm_b32 v68, v142, v138, s35
    v_perm_b32 v69, v150, v146, s35
    v_perm_b32 v70, v158, v154, s35
    v_perm_b32 v71, v166, v162, s35
    v_perm_b32 v72, v143, v139, s34
    v_perm_b32 v73, v151, v147, s34
    v_perm_b32 v74, v159, v155, s34
    v_perm_b32 v75, v167, v163, s34
    v_perm_b32 v76, v143, v139, s35
    s_waitcnt vmcnt(11)
    buffer_load_dwordx4 v[212:215], v1, s[16:19], s47 offen nt
    v_perm_b32 v77, v151, v147, s35
    v_perm_b32 v78, v159, v155, s35
    v_perm_b32 v79, v167, v163, s35
    s_waitcnt lgkmcnt(0)
    v_fma_f32 v96, v96, s33, -v4
    v_fma_f32 v97, v97, s33, -v4
    v_fma_f32 v98, v98, s33, -v4
    v_fma_f32 v99, v99, s33, -v4
    v_fma_f32 v100, v100, s33, -v4
    s_waitcnt vmcnt(11)
    buffer_load_dwordx4 v[216:219], v1, s[16:19], s48 offen nt
    v_fma_f32 v101, v101, s33, -v4
    v_fma_f32 v102, v102, s33, -v4
    v_fma_f32 v103, v103, s33, -v4
    v_exp_f32 v96, v96
    v_exp_f32 v97, v97
    v_exp_f32 v98, v98
    v_exp_f32 v99, v99
    v_exp_f32 v100, v100
    v_exp_f32 v101, v101
    s_waitcnt vmcnt(11)
    buffer_load_dwordx4 v[220:223], v1, s[16:19], s49 offen nt
    v_exp_f32 v102, v102
    v_exp_f32 v103, v103
    s_nop 0
    v_cvt_pk_bf16_f32 v12, v96, v97
    v_cvt_pk_bf16_f32 v13, v98, v99
    v_cvt_pk_bf16_f32 v14, v100, v101
    v_cvt_pk_bf16_f32 v15, v102, v103
    v_add_f32 v8, v96, v97
    v_add_f32 v10, v98, v99
    s_waitcnt vmcnt(11)
    buffer_load_dwordx4 v[224:227], v1, s[16:19], s50 offen nt
    v_mfma_f32_16x16x32_bf16 v[16:19], v[48:51], v[12:15], v[16:19]
    v_add_f32 v11, v100, v101
    v_mfma_f32_16x16x32_bf16 v[20:23], v[52:55], v[12:15], v[20:23]
    v_add_f32 v5, v5, v102
    v_mfma_f32_16x16x32_bf16 v[24:27], v[56:59], v[12:15], v[24:27]
    v_add_f32 v8, v8, v103
    v_mfma_f32_16x16x32_bf16 v[28:31], v[60:63], v[12:15], v[28:31]
    v_add_f32 v10, v10, v11
    v_mfma_f32_16x16x32_bf16 v[32:35], v[64:67], v[12:15], v[32:35]
    s_waitcnt vmcnt(11)
    buffer_load_dwordx4 v[228:231], v1, s[16:19], s51 offen nt
    v_add_f32 v5, v5, v8
    v_mfma_f32_16x16x32_bf16 v[36:39], v[68:71], v[12:15], v[36:39]
    v_add_f32 v5, v5, v10
    v_mfma_f32_16x16x32_bf16 v[40:43], v[72:75], v[12:15], v[40:43]
    v_mfma_f32_16x16x32_bf16 v[44:47], v[76:79], v[12:15], v[44:47]
    ds_read_b128 v[96:99], v91 offset:1024
    ds_read_b128 v[100:103], v91 offset:1040
    s_waitcnt lgkmcnt(0)
    v_fma_f32 v96, v96, s33, -v4
    v_fma_f32 v97, v97, s33, -v4
    v_fma_f32 v98, v98, s33, -v4
    v_fma_f32 v99, v99, s33, -v4
    v_fma_f32 v100, v100, s33, -v4
    v_fma_f32 v101, v101, s33, -v4
    v_fma_f32 v102, v102, s33, -v4
    v_fma_f32 v103, v103, s33, -v4
    v_exp_f32 v96, v96
    v_exp_f32 v97, v97
    v_exp_f32 v98, v98
    v_exp_f32 v99, v99
    v_exp_f32 v100, v100
    v_exp_f32 v101, v101
    v_exp_f32 v102, v102
    v_exp_f32 v103, v103
    s_nop 0
    v_cvt_pk_bf16_f32 v80, v96, v97
    v_cvt_pk_bf16_f32 v81, v98, v99
    v_cvt_pk_bf16_f32 v82, v100, v101
    v_cvt_pk_bf16_f32 v83, v102, v103
    v_add_f32 v8, v96, v97
    v_add_f32 v10, v98, v99
    v_add_f32 v11, v100, v101
    v_add_f32 v5, v5, v102
    v_add_f32 v8, v8, v103
    v_add_f32 v10, v10, v11
    v_add_f32 v5, v5, v8
    v_add_f32 v5, v5, v10
    ds_read_b128 v[96:99], v91 offset:1536
    ds_read_b128 v[100:103], v91 offset:1552
    s_waitcnt lgkmcnt(0)
    v_fma_f32 v96, v96, s33, -v4
    v_fma_f32 v97, v97, s33, -v4
    v_fma_f32 v98, v98, s33, -v4
    v_fma_f32 v99, v99, s33, -v4
    v_fma_f32 v100, v100, s33, -v4
    v_fma_f32 v101, v101, s33, -v4
    v_fma_f32 v102, v102, s33, -v4
    v_fma_f32 v103, v103, s33, -v4
    v_exp_f32 v96, v96
    v_exp_f32 v97, v97
    v_exp_f32 v98, v98
    v_exp_f32 v99, v99
    v_exp_f32 v100, v100
    v_exp_f32 v101, v101
    v_exp_f32 v102, v102
    v_exp_f32 v103, v103
    s_nop 0
    v_cvt_pk_bf16_f32 v84, v96, v97
    v_cvt_pk_bf16_f32 v85, v98, v99
    v_cvt_pk_bf16_f32 v86, v100, v101
    v_cvt_pk_bf16_f32 v87, v102, v103
    v_add_f32 v8, v96, v97
    v_add_f32 v10, v98, v99
    v_add_f32 v11, v100, v101
    v_add_f32 v5, v5, v102
    v_add_f32 v8, v8, v103
    v_add_f32 v10, v10, v11
    v_add_f32 v5, v5, v8
    v_add_f32 v5, v5, v10
    v_mov_b32 v10, v5
    s_nop 1
    v_permlane32_swap_b32 v5, v10
    v_add_f32 v5, v5, v10
    v_mov_b32 v10, v5
    s_nop 1
    v_permlane16_swap_b32 v5, v10
    v_add_f32 v5, v5, v10
    ds_write_b32 v89, v5 offset:64
    s_waitcnt vmcnt(8)
    v_perm_b32 v48, v172, v168, s34
    v_perm_b32 v49, v180, v176, s34
    v_perm_b32 v50, v188, v184, s34
    v_perm_b32 v51, v196, v192, s34
    v_perm_b32 v52, v172, v168, s35
    v_perm_b32 v53, v180, v176, s35
    v_perm_b32 v54, v188, v184, s35
    v_perm_b32 v55, v196, v192, s35
    v_mfma_f32_16x16x32_bf16 v[16:19], v[48:51], v[80:83], v[16:19]
    v_perm_b32 v56, v173, v169, s34
    v_perm_b32 v57, v181, v177, s34
    v_perm_b32 v58, v189, v185, s34
    v_perm_b32 v59, v197, v193, s34
    v_mfma_f32_16x16x32_bf16 v[20:23], v[52:55], v[80:83], v[20:23]
    v_perm_b32 v60, v173, v169, s35
    v_perm_b32 v61, v181, v177, s35
    v_perm_b32 v62, v189, v185, s35
    v_perm_b32 v63, v197, v193, s35
    v_mfma_f32_16x16x32_bf16 v[24:27], v[56:59], v[80:83], v[24:27]
    v_perm_b32 v64, v174, v170, s34
    v_perm_b32 v65, v182, v178, s34
    v_perm_b32 v66, v190, v186, s34
    v_perm_b32 v67, v198, v194, s34
    v_mfma_f32_16x16x32_bf16 v[28:31], v[60:63], v[80:83], v[28:31]
    v_perm_b32 v68, v174, v170, s35
    v_perm_b32 v69, v182, v178, s35
    v_perm_b32 v70, v190, v186, s35
    v_perm_b32 v71, v198, v194, s35
    v_mfma_f32_16x16x32_bf16 v[32:35], v[64:67], v[80:83], v[32:35]
    v_perm_b32 v72, v175, v171, s34
    v_perm_b32 v73, v183, v179, s34
    v_perm_b32 v74, v191, v187, s34
    v_perm_b32 v75, v199, v195, s34
    v_mfma_f32_16x16x32_bf16 v[36:39], v[68:71], v[80:83], v[36:39]
    v_perm_b32 v76, v175, v171, s35
    v_perm_b32 v77, v183, v179, s35
    v_perm_b32 v78, v191, v187, s35
    v_perm_b32 v79, v199, v195, s35
    v_mfma_f32_16x16x32_bf16 v[40:43], v[72:75], v[80:83], v[40:43]
    s_nop 0
    v_mfma_f32_16x16x32_bf16 v[44:47], v[76:79], v[80:83], v[44:47]
    s_waitcnt vmcnt(6)
    v_perm_b32 v48, v204, v200, s34
    v_perm_b32 v52, v204, v200, s35
    v_perm_b32 v56, v205, v201, s34
    v_perm_b32 v60, v205, v201, s35
    v_perm_b32 v64, v206, v202, s34
    v_perm_b32 v68, v206, v202, s35
    v_perm_b32 v72, v207, v203, s34
    v_perm_b32 v76, v207, v203, s35
    s_waitcnt vmcnt(4)
    v_perm_b32 v49, v212, v208, s34
    v_perm_b32 v53, v212, v208, s35
    v_perm_b32 v57, v213, v209, s34
    v_perm_b32 v61, v213, v209, s35
    v_perm_b32 v65, v214, v210, s34
    v_perm_b32 v69, v214, v210, s35
    v_perm_b32 v73, v215, v211, s34
    v_perm_b32 v77, v215, v211, s35
    s_waitcnt vmcnt(2)
    v_perm_b32 v50, v220, v216, s34
    v_perm_b32 v54, v220, v216, s35
    v_perm_b32 v58, v221, v217, s34
    v_perm_b32 v62, v221, v217, s35
    v_perm_b32 v66, v222, v218, s34
    v_perm_b32 v70, v222, v218, s35
    v_perm_b32 v74, v223, v219, s34
    v_perm_b32 v78, v223, v219, s35
    s_waitcnt vmcnt(0)
    v_perm_b32 v51, v228, v224, s34
    v_perm_b32 v55, v228, v224, s35
    v_perm_b32 v59, v229, v225, s34
    v_perm_b32 v63, v229, v225, s35
    v_perm_b32 v67, v230, v226, s34
    v_perm_b32 v71, v230, v226, s35
    v_perm_b32 v75, v231, v227, s34
    v_perm_b32 v79, v231, v227, s35
    v_mfma_f32_16x16x32_bf16 v[16:19], v[48:51], v[84:87], v[16:19]
    v_mfma_f32_16x16x32_bf16 v[20:23], v[52:55], v[84:87], v[20:23]
    v_mfma_f32_16x16x32_bf16 v[24:27], v[56:59], v[84:87], v[24:27]
    v_mfma_f32_16x16x32_bf16 v[28:31], v[60:63], v[84:87], v[28:31]
    v_mfma_f32_16x16x32_bf16 v[32:35], v[64:67], v[84:87], v[32:35]
    v_mfma_f32_16x16x32_bf16 v[36:39], v[68:71], v[84:87], v[36:39]
    v_mfma_f32_16x16x32_bf16 v[40:43], v[72:75], v[84:87], v[40:43]
    v_mfma_f32_16x16x32_bf16 v[44:47], v[76:79], v[84:87], v[44:47]
    s_mov_b32 exec_lo, 0x000f000f
    s_mov_b32 exec_hi, 0x000f000f
    ds_write_b128 v88, v[16:19] offset:8192
    ds_write_b128 v88, v[20:23] offset:8208
    ds_write_b128 v88, v[24:27] offset:8224
    ds_write_b128 v88, v[28:31] offset:8240
    ds_write_b128 v88, v[32:35] offset:8256
    ds_write_b128 v88, v[36:39] offset:8272
    ds_write_b128 v88, v[40:43] offset:8288
    ds_write_b128 v88, v[44:47] offset:8304
    s_mov_b64 exec, -1
    s_waitcnt lgkmcnt(0)
    s_barrier
    ds_read_b128 v[240:243], v235 offset:64
    ds_read_b32 v244, v234 offset:8192
    ds_read_b32 v245, v234 offset:8208
    ds_read_b32 v246, v234 offset:10240
    ds_read_b32 v247, v234 offset:10256
    ds_read_b32 v248, v234 offset:12288
    ds_read_b32 v249, v234 offset:12304
    ds_read_b32 v250, v234 offset:14336
    ds_read_b32 v251, v234 offset:14352
    s_waitcnt lgkmcnt(8)
    v_add_f32 v240, v240, v241
    v_add_f32 v242, v242, v243
    v_add_f32 v240, v240, v242
    v_rcp_f32 v240, v240
    s_waitcnt lgkmcnt(4)
    v_add_f32 v244, v244, v246
    v_add_f32 v245, v245, v247
    s_waitcnt lgkmcnt(0)
    v_add_f32 v248, v248, v250
    v_add_f32 v249, v249, v251
    v_add_f32 v244, v244, v248
    v_add_f32 v245, v245, v249
    v_mul_f32 v244, v244, v240
    v_mul_f32 v245, v245, v240
    v_cvt_pk_bf16_f32 v252, v244, v245
    buffer_store_dword v252, v236, s[28:31], s41 offen
L_end:
    s_endpgm
.section .rodata,"a"
.p2align 6
.amdhsa_kernel standalone__softmax_full_bidir__sampling_kernel
  .amdhsa_next_free_vgpr 256
  .amdhsa_next_free_sgpr 80
  .amdhsa_accum_offset 256
  .amdhsa_group_segment_fixed_size 0
  .amdhsa_kernarg_size 48
  .amdhsa_user_sgpr_count 2
  .amdhsa_user_sgpr_kernarg_segment_ptr 1
  .amdhsa_system_sgpr_workgroup_id_x 1
.end_amdhsa_kernel
```
